```python
import torch

def _softmax(x, axis=-1):
    return torch.softmax(x, dim=axis)
def _gelu(x):
    return torch.nn.functional.gelu(x, approximate="tanh")
def _silu(x):
    return torch.nn.functional.silu(x)
def _sigmoid(x):
    return torch.sigmoid(x)
def _layernorm(x, axis=-1, eps=1e-5):
    m = x.mean(dim=axis, keepdim=True)
    v = x.var(dim=axis, keepdim=True, unbiased=False)
    return (x - m) / torch.sqrt(v + eps)
def _scatter_add(tgt, idx, src, axis=0):
    return tgt.clone().index_add_(axis, idx, src)
def _segment_sum(src, seg, n):
    out = torch.zeros((n,) + src.shape[1:], dtype=src.dtype)
    return out.index_add_(0, seg, src)
def _pad(x, pw):
    flat = tuple(v for pair in reversed(pw) for v in pair)
    return torch.nn.functional.pad(x, flat)

kernel_name = 'standalone__swiglu_ffn__decode'

def setup_inputs():

    _w = (lambda a: (lambda t: t.to(torch.bfloat16) if t.is_floating_point() else t)(torch.as_tensor(a)))
    B, S, D, F = 4, 1, 1024, 3584
    return {
        "x": _w((lambda *s: torch.randn(*s, dtype=torch.bfloat16) * 0.05)(B, S, D)),
        "w_gate": _w((lambda *s: torch.randn(*s, dtype=torch.bfloat16) * 0.05)(D, F)),
        "w_up": _w((lambda *s: torch.randn(*s, dtype=torch.bfloat16) * 0.05)(D, F)),
        "w_down": _w((lambda *s: torch.randn(*s, dtype=torch.bfloat16) * 0.05)(F, D)),
    }

def reference(x, w_gate, w_up, w_down):
    g = _silu(x @ w_gate)
    u = x @ w_up
    return (g * u) @ w_down
```

```asm
; @launch grid=(256,1,1) block=(256,1,1) lds=16384
.amdgcn_target "amdgcn-amd-amdhsa--gfx950"
.text
.fill 512, 4, 0xbf810000
.globl standalone__swiglu_ffn__decode_kernel
.p2align 8
.type standalone__swiglu_ffn__decode_kernel,@function
standalone__swiglu_ffn__decode_kernel:
    s_load_dwordx8 s[4:11], s[0:1], 0
    s_load_dwordx4 s[12:15], s[0:1], 32
    s_load_dwordx2 s[16:17], s[0:1], 48
    v_readfirstlane_b32 s3, v0
    s_cmp_ge_u32 s2, 256
    s_cbranch_scc1 L_end
    s_and_b32 s18, s2, 7
    s_lshr_b32 s19, s2, 5
    s_bfe_u32 s21, s2, 0x20003
    s_add_u32 s22, s18, 3
    s_and_b32 s22, s22, 7
    s_mov_b32 s26, 0xff00ff00
    s_mov_b32 s27, s26
    s_cmp_eq_u32 s19, s22
    s_cselect_b32 s38, 0x00ff00ff, -1
    s_cselect_b32 s23, 0, s26
    s_cmp_eq_u32 s19, 7
    s_cselect_b32 s38, s23, s38
    s_cselect_b32 s22, s22, s19
    s_mov_b32 s39, s38
    s_mul_i32 s20, s18, 7
    s_add_u32 s20, s20, s22
    v_and_b32 v2, 0xf0, v0
    v_lshl_add_u32 v2, s21, 8, v2
    v_mul_u32_u24 v4, 7168, v2
    v_and_b32 v5, 7, v0
    v_lshl_add_u32 v4, v5, 4, v4
    v_add_u32 v4, 3584, v4
    v_lshl_add_u32 v4, s20, 7, v4
    v_mov_b32 v5, 0
    s_mov_b32 s24, 14336
    s_mov_b32 s25, 0
    v_bfe_u32 v6, v0, 2, 2
    v_lshlrev_b32 v6, 11, v6
    v_lshl_add_u32 v6, v2, 1, v6
    v_and_b32 v2, 3, v0
    v_lshlrev_b32 v203, 3, v2
    v_add_u32 v6, v203, v6
    s_lshl_b32 s22, s20, 13
    s_lshl_b32 s23, s21, 10
    s_add_u32 s23, s23, s22
    s_add_u32 s23, s23, 4096
    v_and_b32 v1, 63, v0
    v_bfe_u32 v8, v0, 6, 1
    v_lshrrev_b32 v7, 7, v0
    v_lshl_add_u32 v14, v8, 12, s23
    v_lshl_add_u32 v14, v7, 9, v14
    v_lshl_add_u32 v14, v1, 4, v14
    s_getreg_b32 s50, hwreg(HW_REG_XCC_ID, 0, 4)
    s_add_u32 s50, s50, 1
    s_mov_b32 s51, s50
    s_cmp_lt_u32 s19, 7
    s_cbranch_scc1 L_stream
    s_lshl_b32 s22, s18, 2
    s_add_u32 s22, s22, s21
    s_lshl_b32 s22, s22, 2
    v_mov_b32 v9, s22
    v_mov_b32 v3, s50
    s_cmp_eq_u32 s3, 0
    s_waitcnt lgkmcnt(0)
    s_cbranch_scc0 L_notab
    s_mov_b64 exec, 1
    global_store_dword v9, v3, s[14:15] sc1
    s_mov_b64 exec, -1
L_notab:
    s_cmp_eq_u32 s38, 0
    s_cbranch_scc1 L_hidle
L_stream:
    s_waitcnt lgkmcnt(0)
    v_lshl_add_u64 v[10:11], v[4:5], 0, s[6:7]
    s_mov_b64 exec, s[26:27]
    v_lshl_add_u64 v[10:11], v[4:5], 0, s[8:9]
    s_mov_b64 exec, s[38:39]
    global_load_dwordx4 v[32:35], v[10:11], off offset:-3584 nt
    global_load_dwordx4 v[36:39], v[10:11], off offset:3584 nt
    v_lshl_add_u64 v[10:11], v[10:11], 0, s[24:25]
    global_load_dwordx4 v[40:43], v[10:11], off offset:-3584 nt
    global_load_dwordx4 v[44:47], v[10:11], off offset:3584 nt
    v_lshl_add_u64 v[10:11], v[10:11], 0, s[24:25]
    s_mov_b64 exec, -1
    global_load_dwordx2 v[26:27], v6, s[4:5]
    s_mov_b64 exec, s[38:39]
    global_load_dwordx4 v[48:51], v[10:11], off offset:-3584 nt
    global_load_dwordx4 v[52:55], v[10:11], off offset:3584 nt
    v_lshl_add_u64 v[10:11], v[10:11], 0, s[24:25]
    global_load_dwordx4 v[56:59], v[10:11], off offset:-3584 nt
    global_load_dwordx4 v[60:63], v[10:11], off offset:3584 nt
    v_lshl_add_u64 v[10:11], v[10:11], 0, s[24:25]
    global_load_dwordx4 v[64:67], v[10:11], off offset:-3584 nt
    global_load_dwordx4 v[68:71], v[10:11], off offset:3584 nt
    v_lshl_add_u64 v[10:11], v[10:11], 0, s[24:25]
    global_load_dwordx4 v[72:75], v[10:11], off offset:-3584 nt
    global_load_dwordx4 v[76:79], v[10:11], off offset:3584 nt
    s_mov_b32 exec_lo, -1
    s_mov_b32 exec_hi, 0
    global_load_dword v24, v14, s[16:17]
    s_mov_b64 exec, s[38:39]
    v_lshl_add_u64 v[10:11], v[10:11], 0, s[24:25]
    global_load_dwordx4 v[80:83], v[10:11], off offset:-3584 nt
    global_load_dwordx4 v[84:87], v[10:11], off offset:3584 nt
    v_lshl_add_u64 v[10:11], v[10:11], 0, s[24:25]
    global_load_dwordx4 v[88:91], v[10:11], off offset:-3584 nt
    global_load_dwordx4 v[92:95], v[10:11], off offset:3584 nt
    s_mov_b64 exec, -1
    s_load_dword s28, s[16:17], 0
    s_mov_b32 s34, 0x07060500
    s_bitcmp1_b32 s3, 6
    s_cselect_b32 s48, 8, 0
    s_bitcmp1_b32 s38, s48
    s_cselect_b32 s48, -1, 0
    s_mov_b32 s49, 0
    s_mov_b32 s30, 0x0c0c0100
    s_mov_b32 s31, 0x0c0c0302
    s_mov_b32 vcc_lo, 0x33333333
    s_mov_b32 vcc_hi, 0x33333333
    v_and_b32 v9, 1, v0
    v_lshlrev_b32 v9, 4, v9
    v_alignbit_b32 v2, s30, s30, v9
    v_alignbit_b32 v3, s31, s31, v9
    v_mov_b32 v9, 0x0c0c0c0c
    v_cndmask_b32 v28, v9, v2, vcc
    v_cndmask_b32 v29, v2, v9, vcc
    v_cndmask_b32 v30, v9, v3, vcc
    v_cndmask_b32 v31, v3, v9, vcc
    v_bfe_u32 v9, v0, 4, 2
    v_lshlrev_b32 v9, 2, v9
    v_xor_b32 v9, v9, v1
    v_lshlrev_b32 v12, 4, v9
    v_lshrrev_b32 v3, 6, v0
    v_lshl_add_u32 v12, v3, 11, v12
    v_lshl_add_u32 v8, v8, 1, v7
    v_bfe_u32 v9, v0, 1, 2
    v_xor_b32 v8, v8, v9
    v_bfe_u32 v9, v0, 1, 3
    v_lshlrev_b32 v13, 8, v9
    v_lshl_add_u32 v13, v8, 6, v13
    v_and_b32 v9, 1, v0
    v_lshl_add_u32 v13, v9, 5, v13
    v_bfe_u32 v9, v0, 4, 1
    v_lshl_add_u32 v13, v9, 4, v13
    s_waitcnt vmcnt(13)
    v_mov_b32_dpp v16, v26 quad_perm:[0,0,0,0] row_mask:0xf bank_mask:0xf
    v_mov_b32_dpp v17, v27 quad_perm:[0,0,0,0] row_mask:0xf bank_mask:0xf
    v_mov_b32_dpp v18, v26 quad_perm:[1,1,1,1] row_mask:0xf bank_mask:0xf
    v_mov_b32_dpp v19, v27 quad_perm:[1,1,1,1] row_mask:0xf bank_mask:0xf
    v_mov_b32_dpp v20, v26 quad_perm:[2,2,2,2] row_mask:0xf bank_mask:0xf
    v_mov_b32_dpp v21, v27 quad_perm:[2,2,2,2] row_mask:0xf bank_mask:0xf
    v_mov_b32_dpp v22, v26 quad_perm:[3,3,3,3] row_mask:0xf bank_mask:0xf
    v_mov_b32_dpp v23, v27 quad_perm:[3,3,3,3] row_mask:0xf bank_mask:0xf
    v_perm_b32 v128, v16, v16, v28
    v_perm_b32 v129, v16, v16, v29
    v_perm_b32 v130, v16, v16, v30
    v_perm_b32 v131, v16, v16, v31
    v_perm_b32 v132, v17, v17, v28
    v_perm_b32 v133, v17, v17, v29
    v_perm_b32 v134, v17, v17, v30
    v_perm_b32 v135, v17, v17, v31
    v_perm_b32 v136, v18, v18, v28
    v_perm_b32 v137, v18, v18, v29
    v_perm_b32 v138, v18, v18, v30
    v_perm_b32 v139, v18, v18, v31
    v_perm_b32 v140, v19, v19, v28
    v_perm_b32 v141, v19, v19, v29
    v_perm_b32 v142, v19, v19, v30
    v_perm_b32 v143, v19, v19, v31
    v_perm_b32 v144, v20, v20, v28
    v_perm_b32 v145, v20, v20, v29
    v_perm_b32 v146, v20, v20, v30
    v_perm_b32 v147, v20, v20, v31
    v_perm_b32 v148, v21, v21, v28
    v_perm_b32 v149, v21, v21, v29
    v_perm_b32 v150, v21, v21, v30
    v_perm_b32 v151, v21, v21, v31
    v_perm_b32 v152, v22, v22, v28
    v_perm_b32 v153, v22, v22, v29
    v_perm_b32 v154, v22, v22, v30
    v_perm_b32 v155, v22, v22, v31
    v_perm_b32 v156, v23, v23, v28
    v_perm_b32 v157, v23, v23, v29
    v_perm_b32 v158, v23, v23, v30
    v_perm_b32 v159, v23, v23, v31
    s_cmp_ge_u32 s2, 224
    s_cbranch_scc1 L_helper
    s_lshr_b32 s19, s2, 3
    v_bfe_u32 v2, v0, 4, 2
    v_lshlrev_b32 v4, 13, v2
    v_lshl_add_u32 v4, v3, 16, v4
    v_and_b32 v5, 15, v0
    v_lshl_add_u32 v4, v5, 4, v4
    s_lshl_b32 s22, s19, 18
    s_lshl_b32 s23, s18, 8
    s_add_u32 s22, s22, s23
    s_add_u32 s22, s22, 4096
    v_add_u32 v192, s22, v4
    v_add_u32 v193, 0x8000, v192
    v_bfe_u32 v2, v0, 3, 2
    v_lshl_add_u32 v2, v3, 2, v2
    v_mul_u32_u24 v15, 3584, v2
    v_and_b32 v2, 7, v0
    v_lshl_add_u32 v15, v2, 4, v15
    s_mul_i32 s22, s18, 57344
    s_lshl_b32 s23, s19, 7
    s_add_u32 s22, s22, s23
    s_add_u32 s22, s22, 1048576
    v_add_u32 v15, s22, v15

    s_lshl_b32 s22, s19, 11
    s_add_u32 s22, s22, 524288
    v_lshl_add_u32 v196, v0, 3, s22
    v_lshlrev_b32 v197, 2, v1
    v_lshl_add_u32 v197, v3, 11, v197
    v_lshlrev_b32 v202, 4, v1
    v_lshl_add_u32 v202, v3, 9, v202
    v_mov_b32 v198, 0
    v_mov_b32 v199, 0
    s_mov_b32 s30, 0x05040100
    s_mov_b32 s31, 0x07060302
    s_mov_b32 s33, 0x40000
    s_waitcnt vmcnt(17)
    v_mfma_f32_16x16x16_bf16 v[96:99], v[128:129], v[32:33], 0
    v_mfma_f32_16x16x16_bf16 v[100:103], v[128:129], v[34:35], 0
    s_waitcnt vmcnt(16)
    v_mfma_f32_16x16x16_bf16 v[96:99], v[130:131], v[36:37], v[96:99]
    v_mfma_f32_16x16x16_bf16 v[100:103], v[130:131], v[38:39], v[100:103]
    s_waitcnt vmcnt(15)
    v_mfma_f32_16x16x16_bf16 v[96:99], v[132:133], v[40:41], v[96:99]
    v_mfma_f32_16x16x16_bf16 v[100:103], v[132:133], v[42:43], v[100:103]
    s_waitcnt vmcnt(14)
    v_mfma_f32_16x16x16_bf16 v[96:99], v[134:135], v[44:45], v[96:99]
    v_mfma_f32_16x16x16_bf16 v[100:103], v[134:135], v[46:47], v[100:103]
    s_waitcnt vmcnt(12)
    v_mfma_f32_16x16x16_bf16 v[96:99], v[136:137], v[48:49], v[96:99]
    v_mfma_f32_16x16x16_bf16 v[100:103], v[136:137], v[50:51], v[100:103]
    s_waitcnt vmcnt(11)
    v_mfma_f32_16x16x16_bf16 v[96:99], v[138:139], v[52:53], v[96:99]
    v_mfma_f32_16x16x16_bf16 v[100:103], v[138:139], v[54:55], v[100:103]
    s_waitcnt vmcnt(10)
    v_mfma_f32_16x16x16_bf16 v[96:99], v[140:141], v[56:57], v[96:99]
    v_mfma_f32_16x16x16_bf16 v[100:103], v[140:141], v[58:59], v[100:103]
    s_waitcnt vmcnt(9)
    v_mfma_f32_16x16x16_bf16 v[96:99], v[142:143], v[60:61], v[96:99]
    v_mfma_f32_16x16x16_bf16 v[100:103], v[142:143], v[62:63], v[100:103]
    s_waitcnt lgkmcnt(0)
    s_lshl_b32 s22, s18, 4
    s_load_dwordx4 s[40:43], s[14:15], s22
    s_add_u32 s28, s28, 1
    s_bitset1_b32 s28, 31
    s_and_b32 s52, s28, 0xff
    s_mul_i32 s52, s52, 0x01010100
    s_xor_b32 s52, s52, s28
    v_lshrrev_b32 v25, v203, s52
    s_waitcnt vmcnt(8)
    v_mfma_f32_16x16x16_bf16 v[96:99], v[144:145], v[64:65], v[96:99]
    v_mfma_f32_16x16x16_bf16 v[100:103], v[144:145], v[66:67], v[100:103]
    s_waitcnt vmcnt(7)
    v_mfma_f32_16x16x16_bf16 v[96:99], v[146:147], v[68:69], v[96:99]
    v_mfma_f32_16x16x16_bf16 v[100:103], v[146:147], v[70:71], v[100:103]
    s_waitcnt vmcnt(6)
    global_load_dwordx4 v[160:163], v192, s[10:11] offset:-4096 nt
    global_load_dwordx4 v[164:167], v192, s[10:11] offset:-2048 nt
    global_load_dwordx4 v[168:171], v192, s[10:11] offset:0 nt
    v_mfma_f32_16x16x16_bf16 v[96:99], v[148:149], v[72:73], v[96:99]
    v_mfma_f32_16x16x16_bf16 v[100:103], v[148:149], v[74:75], v[100:103]
    s_waitcnt vmcnt(8)
    v_mfma_f32_16x16x16_bf16 v[96:99], v[150:151], v[76:77], v[96:99]
    v_mfma_f32_16x16x16_bf16 v[100:103], v[150:151], v[78:79], v[100:103]
    s_waitcnt vmcnt(6)
    v_mfma_f32_16x16x16_bf16 v[96:99], v[152:153], v[80:81], v[96:99]
    v_mfma_f32_16x16x16_bf16 v[100:103], v[152:153], v[82:83], v[100:103]
    s_waitcnt vmcnt(5)
    v_mfma_f32_16x16x16_bf16 v[96:99], v[154:155], v[84:85], v[96:99]
    v_mfma_f32_16x16x16_bf16 v[100:103], v[154:155], v[86:87], v[100:103]
    s_waitcnt lgkmcnt(0)
    s_xor_b64 s[40:41], s[40:41], s[50:51]
    s_xor_b64 s[42:43], s[42:43], s[50:51]
    s_or_b64 s[40:41], s[40:41], s[42:43]
    s_waitcnt vmcnt(4)
    v_mfma_f32_16x16x16_bf16 v[96:99], v[156:157], v[88:89], v[96:99]
    v_mfma_f32_16x16x16_bf16 v[100:103], v[156:157], v[90:91], v[100:103]
    s_waitcnt vmcnt(3)
    v_mfma_f32_16x16x16_bf16 v[96:99], v[158:159], v[92:93], v[96:99]
    v_mfma_f32_16x16x16_bf16 v[100:103], v[158:159], v[94:95], v[100:103]
    s_nop 6
    ds_write_b128 v12, v[96:99]
    ds_write_b128 v12, v[100:103] offset:1024
    s_mov_b64 exec, s[48:49]
    s_waitcnt lgkmcnt(0)
    s_barrier
    s_cbranch_execz L_pub_done
    ds_read_b128 v[32:35], v13 offset:0
    ds_read_b128 v[36:39], v13 offset:2048
    ds_read_b128 v[40:43], v13 offset:4096
    ds_read_b128 v[44:47], v13 offset:6144
    s_waitcnt lgkmcnt(2)
    v_pk_add_f32 v[32:33], v[32:33], v[36:37]
    v_pk_add_f32 v[34:35], v[34:35], v[38:39]
    s_waitcnt lgkmcnt(1)
    v_pk_add_f32 v[32:33], v[32:33], v[40:41]
    v_pk_add_f32 v[34:35], v[34:35], v[42:43]
    s_waitcnt lgkmcnt(0)
    v_pk_add_f32 v[32:33], v[32:33], v[44:45]
    v_pk_add_f32 v[34:35], v[34:35], v[46:47]
    v_perm_b32 v32, v32, v25, s34
    s_cbranch_scc1 L_pub_far
    global_store_dwordx4 v14, v[32:35], s[16:17]
L_pub_done:
    s_mov_b64 exec, -1
    s_barrier
    global_load_dwordx4 v[172:175], v192, s[10:11] offset:2048 nt
    global_load_dwordx4 v[176:179], v193, s[10:11] offset:-4096 nt
    global_load_dwordx4 v[180:183], v193, s[10:11] offset:-2048 nt
    global_load_dwordx4 v[184:187], v193, s[10:11] offset:0 nt
    global_load_dwordx4 v[188:191], v193, s[10:11] offset:2048 nt
    s_waitcnt vmcnt(6)
    v_perm_b32 v128, v164, v160, s30
    v_perm_b32 v132, v164, v160, s31
    v_perm_b32 v136, v165, v161, s30
    v_perm_b32 v140, v165, v161, s31
    v_perm_b32 v144, v166, v162, s30
    v_perm_b32 v148, v166, v162, s31
    v_perm_b32 v152, v167, v163, s30
    v_perm_b32 v156, v167, v163, s31
    s_waitcnt vmcnt(4)
    global_atomic_add_x2 v[200:201], v196, v[198:199], s[16:17] sc0
    v_perm_b32 v129, v172, v168, s30
    v_perm_b32 v133, v172, v168, s31
    v_perm_b32 v137, v173, v169, s30
    v_perm_b32 v141, v173, v169, s31
    v_perm_b32 v145, v174, v170, s30
    v_perm_b32 v149, v174, v170, s31
    v_perm_b32 v153, v175, v171, s30
    v_perm_b32 v157, v175, v171, s31
    s_waitcnt vmcnt(3)
    v_perm_b32 v130, v180, v176, s30
    v_perm_b32 v134, v180, v176, s31
    v_perm_b32 v138, v181, v177, s30
    v_perm_b32 v142, v181, v177, s31
    v_perm_b32 v146, v182, v178, s30
    v_perm_b32 v150, v182, v178, s31
    v_perm_b32 v154, v183, v179, s30
    v_perm_b32 v158, v183, v179, s31
    s_waitcnt vmcnt(1)
    v_perm_b32 v131, v188, v184, s30
    v_perm_b32 v135, v188, v184, s31
    v_perm_b32 v139, v189, v185, s30
    v_perm_b32 v143, v189, v185, s31
    v_perm_b32 v147, v190, v186, s30
    v_perm_b32 v151, v190, v186, s31
    v_perm_b32 v155, v191, v187, s30
    v_perm_b32 v159, v191, v187, s31
L_pollh:
    s_waitcnt vmcnt(0)
    v_perm_b32 v9, v201, v200, s31
    v_cmp_ne_u32_sdwa vcc, v200, s52 src0_sel:WORD_0 src1_sel:WORD_0
    v_cmp_ne_u32_sdwa s[44:45], v201, s52 src0_sel:WORD_0 src1_sel:WORD_1
    v_mov_b32_dpp v16, v9 quad_perm:[0,0,0,0] row_mask:0xf bank_mask:0xf
    v_mov_b32_dpp v17, v9 quad_perm:[1,1,1,1] row_mask:0xf bank_mask:0xf
    v_mov_b32_dpp v18, v9 quad_perm:[2,2,2,2] row_mask:0xf bank_mask:0xf
    v_mov_b32_dpp v19, v9 quad_perm:[3,3,3,3] row_mask:0xf bank_mask:0xf
    s_or_b64 s[44:45], s[44:45], vcc
    s_cbranch_scc1 L_pollh_again
L_pollh_done:
    v_mfma_f32_16x16x32_bf16 v[96:99], v[16:19], v[128:131], 0
    v_mfma_f32_16x16x32_bf16 v[100:103], v[16:19], v[132:135], 0
    v_mfma_f32_16x16x32_bf16 v[104:107], v[16:19], v[136:139], 0
    v_mfma_f32_16x16x32_bf16 v[108:111], v[16:19], v[140:143], 0
    v_mfma_f32_16x16x32_bf16 v[112:115], v[16:19], v[144:147], 0
    v_mfma_f32_16x16x32_bf16 v[116:119], v[16:19], v[148:151], 0
    v_mfma_f32_16x16x32_bf16 v[120:123], v[16:19], v[152:155], 0
    v_mfma_f32_16x16x32_bf16 v[124:127], v[16:19], v[156:159], 0
    s_cmp_lg_u64 s[40:41], 0
    s_nop 0
    ds_write2st64_b32 v197, v96, v100 offset0:32 offset1:33
    s_nop 0
    ds_write2st64_b32 v197, v104, v108 offset0:34 offset1:35
    s_nop 0
    ds_write2st64_b32 v197, v112, v116 offset0:36 offset1:37
    s_nop 0
    ds_write2st64_b32 v197, v120, v124 offset0:38 offset1:39
    s_mov_b32 exec_hi, 0
    s_waitcnt lgkmcnt(0)
    s_barrier
    ds_read_b128 v[32:35], v202 offset:8192
    ds_read_b128 v[36:39], v202 offset:10240
    ds_read_b128 v[40:43], v202 offset:12288
    ds_read_b128 v[44:47], v202 offset:14336
    s_waitcnt lgkmcnt(2)
    v_pk_add_f32 v[32:33], v[32:33], v[36:37]
    v_pk_add_f32 v[34:35], v[34:35], v[38:39]
    s_waitcnt lgkmcnt(1)
    v_pk_add_f32 v[32:33], v[32:33], v[40:41]
    v_pk_add_f32 v[34:35], v[34:35], v[42:43]
    s_waitcnt lgkmcnt(0)
    v_pk_add_f32 v[32:33], v[32:33], v[44:45]
    v_pk_add_f32 v[34:35], v[34:35], v[46:47]
    v_perm_b32 v32, v32, v25, s34
    s_cbranch_scc1 L_pub2_far
    global_store_dwordx4 v15, v[32:35], s[16:17]
L_pub2_done:
    s_endpgm
L_pollh_again:
    global_atomic_add_x2 v[200:201], v196, v[198:199], s[16:17] sc0
    s_sub_u32 s33, s33, 1
    s_cbranch_scc0 L_pollh
    s_branch L_pollh_done
L_pub_far:
    global_store_dwordx4 v14, v[32:35], s[16:17] sc1
    s_branch L_pub_done
L_pub2_far:
    global_store_dwordx4 v15, v[32:35], s[16:17] sc1
    s_branch L_pub2_done
L_hpub_far:
    global_store_dwordx4 v14, v[32:35], s[16:17] sc1
    s_branch L_hpub_done
L_hidle:
    s_load_dword s28, s[16:17], 0
    s_lshr_b32 s19, s3, 6
    s_lshl_b32 s22, s21, 2
    s_add_u32 s19, s19, s22
    s_mul_i32 s44, s18, 14
    s_add_u32 s44, s44, s19
    s_lshr_b32 s22, s44, 1
    s_lshl_b32 s22, s22, 13
    s_and_b32 s23, s44, 1
    s_lshl_b32 s23, s23, 9
    s_add_u32 s22, s22, s23
    s_add_u32 s22, s22, 8192
    v_lshl_add_u32 v192, v1, 3, s22
    s_and_b32 s22, s44, 0
    s_add_u32 s22, s22, s44
    s_lshl_b32 s22, s22, 9
    s_add_u32 s22, s22, 524288
    v_lshl_add_u32 v193, v1, 3, s22
    v_add_u32 v200, 8192, v193
    v_bfe_u32 v4, v0, 1, 2
    v_lshlrev_b32 v194, 3, v4
    v_and_b32 v4, 1, v0
    v_sub_u32 v4, 1, v4
    v_mul_u32_u24 v195, 0xff, v4
    s_mul_i32 s22, s19, 3584
    s_mul_i32 s23, s18, 57344
    s_add_u32 s22, s22, s23
    s_add_u32 s22, s22, 1048576
    v_lshl_add_u32 v196, v1, 4, s22
    s_and_b32 s22, s19, 1
    s_lshl_b32 s22, s22, 12
    s_lshl_b32 s23, s18, 8
    s_add_u32 s22, s22, s23
    s_and_b32 s23, s19, 14
    s_add_u32 s22, s22, s23
    v_bfe_u32 v2, v0, 2, 1
    v_lshl_add_u32 v197, v2, 11, s22
    v_and_b32 v2, 3, v0
    v_lshl_add_u32 v197, v2, 6, v197
    v_bfe_u32 v2, v0, 4, 1
    v_lshl_add_u32 v197, v2, 5, v197
    v_bfe_u32 v2, v0, 5, 1
    v_lshl_add_u32 v197, v2, 4, v197
    v_mov_b32 v173, 0
    v_mov_b32 v174, 0
    v_mov_b32 v175, 0
    s_mov_b32 s30, 0x05040100
    s_mov_b32 s31, 0x07060302
    s_mov_b32 s33, 0x40000
    s_mov_b32 s26, 0x00ff00ff
    s_mov_b32 s27, s26
    s_waitcnt lgkmcnt(0)
    s_add_u32 s28, s28, 1
    s_bitset1_b32 s28, 31
    s_and_b32 s52, s28, 0xff
    s_mul_i32 s52, s52, 0x01010100
    s_xor_b32 s52, s52, s28
    v_lshrrev_b32 v25, v203, s52
    s_branch L_hjob
L_helper:
    s_lshr_b32 s19, s3, 6
    s_lshl_b32 s22, s21, 2
    s_add_u32 s19, s19, s22
    s_mul_i32 s44, s18, 14
    s_add_u32 s44, s44, s19
    s_lshr_b32 s22, s44, 1
    s_lshl_b32 s22, s22, 13
    s_and_b32 s23, s44, 1
    s_lshl_b32 s23, s23, 9
    s_add_u32 s22, s22, s23
    s_add_u32 s22, s22, 8192
    v_lshl_add_u32 v192, v1, 3, s22
    s_and_b32 s22, s44, 0
    s_add_u32 s22, s22, s44
    s_lshl_b32 s22, s22, 9
    s_add_u32 s22, s22, 524288
    v_lshl_add_u32 v193, v1, 3, s22
    v_add_u32 v200, 8192, v193
    v_bfe_u32 v4, v0, 1, 2
    v_lshlrev_b32 v194, 3, v4
    v_and_b32 v4, 1, v0
    v_sub_u32 v4, 1, v4
    v_mul_u32_u24 v195, 0xff, v4
    s_mul_i32 s22, s19, 3584
    s_mul_i32 s23, s18, 57344
    s_add_u32 s22, s22, s23
    s_add_u32 s22, s22, 1048576
    v_lshl_add_u32 v196, v1, 4, s22
    s_and_b32 s22, s19, 1
    s_lshl_b32 s22, s22, 12
    s_lshl_b32 s23, s18, 8
    s_add_u32 s22, s22, s23
    s_and_b32 s23, s19, 14
    s_add_u32 s22, s22, s23
    v_bfe_u32 v2, v0, 2, 1
    v_lshl_add_u32 v197, v2, 11, s22
    v_and_b32 v2, 3, v0
    v_lshl_add_u32 v197, v2, 6, v197
    v_bfe_u32 v2, v0, 4, 1
    v_lshl_add_u32 v197, v2, 5, v197
    v_bfe_u32 v2, v0, 5, 1
    v_lshl_add_u32 v197, v2, 4, v197
    v_mov_b32 v173, 0
    v_mov_b32 v174, 0
    v_mov_b32 v175, 0
    s_mov_b32 s30, 0x05040100
    s_mov_b32 s31, 0x07060302
    s_mov_b32 s33, 0x40000
    s_mov_b32 s26, 0x00ff00ff
    s_mov_b32 s27, s26
    s_waitcnt vmcnt(17)
    v_mfma_f32_16x16x16_bf16 v[96:99], v[128:129], v[32:33], 0
    v_mfma_f32_16x16x16_bf16 v[100:103], v[128:129], v[34:35], 0
    s_waitcnt vmcnt(16)
    v_mfma_f32_16x16x16_bf16 v[96:99], v[130:131], v[36:37], v[96:99]
    v_mfma_f32_16x16x16_bf16 v[100:103], v[130:131], v[38:39], v[100:103]
    s_waitcnt vmcnt(15)
    v_mfma_f32_16x16x16_bf16 v[96:99], v[132:133], v[40:41], v[96:99]
    v_mfma_f32_16x16x16_bf16 v[100:103], v[132:133], v[42:43], v[100:103]
    s_waitcnt vmcnt(14)
    v_mfma_f32_16x16x16_bf16 v[96:99], v[134:135], v[44:45], v[96:99]
    v_mfma_f32_16x16x16_bf16 v[100:103], v[134:135], v[46:47], v[100:103]
    s_waitcnt vmcnt(12)
    v_mfma_f32_16x16x16_bf16 v[96:99], v[136:137], v[48:49], v[96:99]
    v_mfma_f32_16x16x16_bf16 v[100:103], v[136:137], v[50:51], v[100:103]
    s_waitcnt vmcnt(11)
    v_mfma_f32_16x16x16_bf16 v[96:99], v[138:139], v[52:53], v[96:99]
    v_mfma_f32_16x16x16_bf16 v[100:103], v[138:139], v[54:55], v[100:103]
    s_waitcnt vmcnt(10)
    v_mfma_f32_16x16x16_bf16 v[96:99], v[140:141], v[56:57], v[96:99]
    v_mfma_f32_16x16x16_bf16 v[100:103], v[140:141], v[58:59], v[100:103]
    s_waitcnt vmcnt(9)
    v_mfma_f32_16x16x16_bf16 v[96:99], v[142:143], v[60:61], v[96:99]
    v_mfma_f32_16x16x16_bf16 v[100:103], v[142:143], v[62:63], v[100:103]
    s_waitcnt lgkmcnt(0)
    s_lshl_b32 s22, s18, 4
    s_load_dwordx4 s[40:43], s[14:15], s22
    s_add_u32 s28, s28, 1
    s_bitset1_b32 s28, 31
    s_and_b32 s52, s28, 0xff
    s_mul_i32 s52, s52, 0x01010100
    s_xor_b32 s52, s52, s28
    v_lshrrev_b32 v25, v203, s52
    s_waitcnt vmcnt(8)
    v_mfma_f32_16x16x16_bf16 v[96:99], v[144:145], v[64:65], v[96:99]
    v_mfma_f32_16x16x16_bf16 v[100:103], v[144:145], v[66:67], v[100:103]
    s_waitcnt vmcnt(7)
    v_mfma_f32_16x16x16_bf16 v[96:99], v[146:147], v[68:69], v[96:99]
    v_mfma_f32_16x16x16_bf16 v[100:103], v[146:147], v[70:71], v[100:103]
    s_waitcnt vmcnt(6)
    v_mfma_f32_16x16x16_bf16 v[96:99], v[148:149], v[72:73], v[96:99]
    v_mfma_f32_16x16x16_bf16 v[100:103], v[148:149], v[74:75], v[100:103]
    s_waitcnt vmcnt(5)
    v_mfma_f32_16x16x16_bf16 v[96:99], v[150:151], v[76:77], v[96:99]
    v_mfma_f32_16x16x16_bf16 v[100:103], v[150:151], v[78:79], v[100:103]
    s_waitcnt vmcnt(3)
    v_mfma_f32_16x16x16_bf16 v[96:99], v[152:153], v[80:81], v[96:99]
    v_mfma_f32_16x16x16_bf16 v[100:103], v[152:153], v[82:83], v[100:103]
    s_waitcnt vmcnt(2)
    v_mfma_f32_16x16x16_bf16 v[96:99], v[154:155], v[84:85], v[96:99]
    v_mfma_f32_16x16x16_bf16 v[100:103], v[154:155], v[86:87], v[100:103]
    s_waitcnt lgkmcnt(0)
    s_xor_b64 s[40:41], s[40:41], s[50:51]
    s_xor_b64 s[42:43], s[42:43], s[50:51]
    s_or_b64 s[40:41], s[40:41], s[42:43]
    s_waitcnt vmcnt(1)
    v_mfma_f32_16x16x16_bf16 v[96:99], v[156:157], v[88:89], v[96:99]
    v_mfma_f32_16x16x16_bf16 v[100:103], v[156:157], v[90:91], v[100:103]
    s_waitcnt vmcnt(0)
    v_mfma_f32_16x16x16_bf16 v[96:99], v[158:159], v[92:93], v[96:99]
    v_mfma_f32_16x16x16_bf16 v[100:103], v[158:159], v[94:95], v[100:103]
    s_nop 6
    ds_write_b128 v12, v[96:99]
    ds_write_b128 v12, v[100:103] offset:1024
    s_mov_b64 exec, s[48:49]
    s_waitcnt lgkmcnt(0)
    s_barrier
    s_cbranch_execz L_hpub_done
    ds_read_b128 v[32:35], v13 offset:0
    ds_read_b128 v[36:39], v13 offset:2048
    ds_read_b128 v[40:43], v13 offset:4096
    ds_read_b128 v[44:47], v13 offset:6144
    s_waitcnt lgkmcnt(2)
    v_pk_add_f32 v[32:33], v[32:33], v[36:37]
    v_pk_add_f32 v[34:35], v[34:35], v[38:39]
    s_waitcnt lgkmcnt(1)
    v_pk_add_f32 v[32:33], v[32:33], v[40:41]
    v_pk_add_f32 v[34:35], v[34:35], v[42:43]
    s_waitcnt lgkmcnt(0)
    v_pk_add_f32 v[32:33], v[32:33], v[44:45]
    v_pk_add_f32 v[34:35], v[34:35], v[46:47]
    v_perm_b32 v32, v32, v25, s34
    s_cbranch_scc1 L_hpub_far
    global_store_dwordx4 v14, v[32:35], s[16:17]
L_hpub_done:
    s_mov_b64 exec, -1
L_hjob:
    v_lshrrev_b32 v194, v194, s52
    v_mov_b32 v198, s52
    s_movk_i32 s45, 0x80
    s_mov_b32 s46, 0xbfb8aa3b
    s_mov_b32 s47, s46
    s_cmp_ge_u32 s19, 14
    s_cbranch_scc1 L_hbar
L_poll1:
    global_load_dwordx2 v[48:49], v192, s[16:17] offset:-4096 sc1
    global_load_dwordx2 v[50:51], v192, s[16:17] offset:-3072 sc1
    global_load_dwordx2 v[52:53], v192, s[16:17] offset:-2048 sc1
    global_load_dwordx2 v[54:55], v192, s[16:17] offset:-1024 sc1
    global_load_dwordx2 v[56:57], v192, s[16:17] offset:0 sc1
    global_load_dwordx2 v[58:59], v192, s[16:17] offset:1024 sc1
    global_load_dwordx2 v[60:61], v192, s[16:17] offset:2048 sc1
    global_load_dwordx2 v[62:63], v192, s[16:17] offset:3072 sc1
    s_sub_u32 s33, s33, 1
    s_cbranch_scc1 L_poll1_done
    s_waitcnt vmcnt(6)
    v_bitop3_b32 v72, v194, v48, v50 bitop3:0x7e
    v_bfi_b32 v48, v195, s45, v48
    v_bfi_b32 v50, v195, s45, v50
    v_pk_add_f32 v[76:77], v[48:49], v[50:51]
    s_waitcnt vmcnt(4)
    v_bitop3_b32 v73, v194, v52, v54 bitop3:0x7e
    v_bfi_b32 v52, v195, s45, v52
    v_bfi_b32 v54, v195, s45, v54
    v_pk_add_f32 v[78:79], v[52:53], v[54:55]
    v_pk_add_f32 v[64:65], v[76:77], v[78:79]
    s_waitcnt vmcnt(2)
    v_bitop3_b32 v74, v194, v56, v58 bitop3:0x7e
    v_cvt_pk_bf16_f32 v68, v64, v65
    v_or3_b32 v72, v72, v73, v74
    v_lshlrev_b32 v64, 16, v68
    v_and_b32 v65, 0xffff0000, v68
    s_waitcnt vmcnt(0)
    v_bitop3_b32 v75, v194, v60, v62 bitop3:0x7e
    v_bitop3_b32 v72, v72, v75, v195 bitop3:0xa8
    v_cmp_ne_u32 vcc, 0, v72
    v_pk_mul_f32 v[70:71], v[64:65], s[46:47]
    s_cbranch_vccnz L_poll1
L_poll1_done:
    v_exp_f32 v70, v70
    v_exp_f32 v71, v71
    v_bfi_b32 v56, v195, s45, v56
    v_bfi_b32 v58, v195, s45, v58
    v_pk_add_f32 v[70:71], v[70:71], 1.0 op_sel_hi:[1,0]
    v_bfi_b32 v60, v195, s45, v60
    v_rcp_f32 v70, v70
    v_rcp_f32 v71, v71
    v_bfi_b32 v62, v195, s45, v62
    v_pk_add_f32 v[80:81], v[56:57], v[58:59]
    v_pk_add_f32 v[82:83], v[60:61], v[62:63]
    v_pk_mul_f32 v[70:71], v[64:65], v[70:71]
    v_pk_add_f32 v[66:67], v[80:81], v[82:83]
    v_cvt_pk_bf16_f32 v71, v70, v71
    v_cvt_pk_bf16_f32 v69, v66, v67
    v_lshlrev_b32 v70, 16, v71
    v_and_b32 v71, 0xffff0000, v71
    v_lshlrev_b32 v66, 16, v69
    v_and_b32 v67, 0xffff0000, v69
    v_pk_mul_f32 v[70:71], v[70:71], v[66:67]
    v_cvt_pk_bf16_f32 v71, v70, v71
    v_perm_b32 v70, v71, v198, s30
    v_perm_b32 v71, v71, v198, s31
    s_barrier
    global_store_dwordx2 v193, v[70:71], s[16:17] sc1
L_cjob:
    global_load_ushort v7, v197, s[12:13]
    s_mov_b32 s33, 0x40000
    v_mov_b32 v199, 0xff
    v_not_b32 v160, v25
    v_not_b32 v164, v25
    v_not_b32 v168, v25
    v_and_b32 v172, 0xff, v25
    s_mov_b32 exec_hi, 0
    v_not_b32 v172, v25
    s_mov_b64 s[4:5], -1
    s_mov_b64 s[6:7], -1
    s_mov_b64 s[8:9], -1
    s_mov_b64 s[10:11], exec
L_poll2:
    s_wqm_b64 exec, s[4:5]
    global_load_dwordx4 v[160:163], v196, s[16:17] offset:0 sc1
    s_wqm_b64 exec, s[6:7]
    global_load_dwordx4 v[164:167], v196, s[16:17] offset:1024 sc1
    s_wqm_b64 exec, s[8:9]
    global_load_dwordx4 v[168:171], v196, s[16:17] offset:2048 sc1
    s_wqm_b64 exec, s[10:11]
    global_load_dwordx4 v[172:175], v196, s[16:17] offset:3072 sc1
    s_mov_b64 exec, -1
    s_sub_u32 s33, s33, 1
    s_cbranch_scc1 L_poll2_done
    s_waitcnt vmcnt(0)
    v_cmp_ne_u32_sdwa s[4:5], v160, v25 src0_sel:BYTE_0 src1_sel:BYTE_0
    v_cmp_ne_u32_sdwa s[6:7], v164, v25 src0_sel:BYTE_0 src1_sel:BYTE_0
    v_cmp_ne_u32_sdwa s[8:9], v168, v25 src0_sel:BYTE_0 src1_sel:BYTE_0
    v_cmp_ne_u32_sdwa s[10:11], v172, v25 src0_sel:BYTE_0 src1_sel:BYTE_0
    v_pk_add_f32 v[34:35], v[162:163], v[166:167]
    s_or_b64 s[42:43], s[4:5], s[6:7]
    s_or_b64 s[46:47], s[8:9], s[10:11]
    s_or_b64 s[42:43], s[42:43], s[46:47]
    s_cbranch_scc1 L_poll2
L_poll2_done:
    v_bfi_b32 v160, v199, s45, v160
    v_bfi_b32 v164, v199, s45, v164
    v_bfi_b32 v168, v199, s45, v168
    v_bfi_b32 v172, v199, s45, v172
    v_pk_add_f32 v[32:33], v[160:161], v[164:165]
    v_pk_add_f32 v[36:37], v[168:169], v[172:173]
    v_pk_add_f32 v[38:39], v[170:171], v[174:175]
    v_pk_add_f32 v[32:33], v[32:33], v[36:37]
    v_pk_add_f32 v[34:35], v[34:35], v[38:39]
    s_nop 0
    v_permlane32_swap_b32 v32, v33
    v_permlane32_swap_b32 v34, v35
    v_add_f32 v32, v32, v33
    v_add_f32 v34, v34, v35
    s_nop 1
    v_permlane16_swap_b32 v32, v34
    v_add_f32 v32, v32, v34
    s_nop 1
    v_add_f32_dpp v32, v32, v32 row_ror:8 row_mask:0xf bank_mask:0xf
    v_cvt_pk_bf16_f32 v32, v32, v32
    s_mov_b64 exec, s[26:27]
    global_store_short v197, v32, s[12:13]
    s_add_u32 s22, s18, s19
    s_cmp_eq_u32 s22, 0
    s_cbranch_scc0 L_c_noupd
    v_mov_b32 v6, 0
    v_mov_b32 v7, s28
    s_mov_b64 exec, 1
    global_store_dword v6, v7, s[16:17]
L_c_noupd:
    s_endpgm
L_hbar:
    s_barrier

    s_branch L_cjob
L_end:
    s_endpgm
.section .rodata,"a"
.p2align 6
.amdhsa_kernel standalone__swiglu_ffn__decode_kernel
  .amdhsa_next_free_vgpr 208
  .amdhsa_next_free_sgpr 56
  .amdhsa_accum_offset 208
  .amdhsa_group_segment_fixed_size 0
  .amdhsa_kernarg_size 56
  .amdhsa_user_sgpr_count 2
  .amdhsa_user_sgpr_kernarg_segment_ptr 1
  .amdhsa_system_sgpr_workgroup_id_x 1
  .amdhsa_float_denorm_mode_32 3
.end_amdhsa_kernel
```
